```python
import torch

def _softmax(x, axis=-1):
    return torch.softmax(x, dim=axis)
def _gelu(x):
    return torch.nn.functional.gelu(x, approximate="tanh")
def _silu(x):
    return torch.nn.functional.silu(x)
def _sigmoid(x):
    return torch.sigmoid(x)
def _layernorm(x, axis=-1, eps=1e-5):
    m = x.mean(dim=axis, keepdim=True)
    v = x.var(dim=axis, keepdim=True, unbiased=False)
    return (x - m) / torch.sqrt(v + eps)
def _scatter_add(tgt, idx, src, axis=0):
    return tgt.clone().index_add_(axis, idx, src)
def _segment_sum(src, seg, n):
    out = torch.zeros((n,) + src.shape[1:], dtype=src.dtype)
    return out.index_add_(0, seg, src)
def _pad(x, pw):
    flat = tuple(v for pair in reversed(pw) for v in pair)
    return torch.nn.functional.pad(x, flat)

kernel_name = 'standalone__paged_block_table_kv_radixattention__decode'

def setup_inputs():

    _w = (lambda a: (lambda t: t.to(torch.bfloat16) if t.is_floating_point() else t)(torch.as_tensor(a)))
    B, H, Hkv, Dh = 4, 32, 8, 128
    Lk = 8192
    bs = 16
    nb = max(2, Lk // bs)
    P = max(1, nb // 2)
    n_phys = P + B * (nb - P)
    shared = torch.arange(P, dtype=torch.int64)
    priv = P + torch.arange(B * (nb - P), dtype=torch.int64).reshape(B, nb - P)
    bt = torch.cat([torch.tile(shared[None, :], (B, 1)), priv], dim=1)
    ctx = nb * bs - (torch.arange(1, B + 1, dtype=torch.int64) * 2654435761) % max(1, (nb * bs - P * bs) // 2)
    return {
        "q": _w((lambda *s: torch.randn(*s, dtype=torch.bfloat16) * 0.8)(B, H, Dh)),
        "k_cache": _w((lambda *s: torch.randn(*s, dtype=torch.bfloat16) * 0.8)(n_phys, bs, Hkv, Dh)),
        "v_cache": _w((lambda *s: torch.randn(*s, dtype=torch.bfloat16) * 0.05)(n_phys, bs, Hkv, Dh)),
        "block_table": _w(bt.to(torch.int64)),
        "ctx_lens": _w(torch.as_tensor(ctx).to(torch.int64)),
    }

def reference(q, k_cache, v_cache, block_table, ctx_lens):
    B, H, Dh = q.shape
    n_phys, bs, Hkv, _ = k_cache.shape
    nb = block_table.shape[1]
    Lk = nb * bs
    rep = H // Hkv
    k = k_cache[block_table].reshape(B, Lk, Hkv, Dh)
    v = v_cache[block_table].reshape(B, Lk, Hkv, Dh)
    k = (lambda x, n, axis: torch.repeat_interleave(x, n, dim=axis))(k, rep, axis=2)
    v = (lambda x, n, axis: torch.repeat_interleave(x, n, dim=axis))(v, rep, axis=2)
    scores = torch.einsum("bhd,bkhd->bhk", q, k) * (Dh ** -0.5)
    pos = torch.arange(Lk)
    valid = pos[None, :] < ctx_lens[:, None]
    scores = torch.where(valid[:, None, :], scores, -1e9)
    p = _softmax(scores, axis=-1)
    return torch.einsum("bhk,bkhd->bhd", p, v)
```

```asm
; @launch grid=(256,1,1) block=(640,1,1) lds=148544
.amdgcn_target "amdgcn-amd-amdhsa--gfx950"
.text
.globl standalone__paged_block_table_kv_radixattention__decode_kernel
.p2align 12
.p2align 8
.type standalone__paged_block_table_kv_radixattention__decode_kernel,@function
standalone__paged_block_table_kv_radixattention__decode_kernel:
    s_lshr_b32 s36, s2, 3
    s_load_dwordx16 s[4:19], s[0:1], 0
    v_readfirstlane_b32 s32, v0
    s_cmp_ge_u32 s36, 32
    s_cbranch_scc1 L_end
    s_and_b32 s34, s2, 7
    s_lshl_b32 s37, s36, 5
    s_lshl_b32 s39, s36, 1
    s_cmp_gt_u32 s36, 15
    s_cselect_b32 s40, 5, 0
    s_add_u32 s39, s39, s40
    s_cmp_gt_u32 s36, 21
    s_cselect_b32 s40, 10, 0
    s_add_u32 s39, s39, s40
    s_mul_i32 s40, s36, 29
    s_add_u32 s40, s40, 82
    s_cmp_ge_u32 s36, 27
    s_cselect_b32 s39, 0, s39
    s_cselect_b32 s35, 30, 32
    s_cmp_gt_u32 s36, 27
    s_cselect_b32 s37, s40, s37
    s_cselect_b32 s35, 29, s35
    s_lshl_b32 s45, s36, 1
    s_or_b32 s45, s45, 1
    s_cmp_ge_u32 s36, 27
    s_cselect_b32 s45, 1, s45
    s_lshr_b32 s32, s32, 6
    s_cbranch_scc0 L_loader
    s_cmp_eq_u32 s32, 1
    s_cbranch_scc1 L_w1
    s_cmp_eq_u32 s32, 2
    s_cbranch_scc1 L_w2
    s_cmp_eq_u32 s32, 3
    s_cbranch_scc1 L_w3
    s_cmp_eq_u32 s32, 4
    s_cbranch_scc1 L_w4
    s_cmp_eq_u32 s32, 5
    s_cbranch_scc1 L_w5
    s_cmp_eq_u32 s32, 6
    s_cbranch_scc1 L_w6
    s_cmp_eq_u32 s32, 7
    s_cbranch_scc1 L_w7
    s_cmp_eq_u32 s32, 8
    s_cbranch_scc1 L_w8
    s_branch L_w9
L_loader:
    s_mov_b32 s33, 0x1b1e500
    s_cmp_gt_u32 s36, 15
    s_cselect_b32 s33, 0x362af1b, s33
    s_cmp_gt_u32 s36, 21
    s_cselect_b32 s33, 0x5135e51, s33
    s_cmp_gt_u32 s36, 26
    s_cselect_b32 s33, 0x3f2a2, s33
    v_lshrrev_b32 v3, 4, v0
    v_and_b32 v2, 15, v0
    s_lshl_b32 s34, s34, 8
    v_lshlrev_b32 v9, 11, v3
    v_xor_b32 v8, v2, v3
    v_add_u32 v9, s34, v9
    v_lshl_add_u32 v28, v8, 4, v9
    v_xor_b32 v29, 64, v28
    v_add_u32 v29, 7168, v29
    v_xor_b32 v30, 128, v28
    v_add_u32 v30, 14336, v30
    v_xor_b32 v31, 192, v28
    v_add_u32 v31, 21504, v31
    s_and_b32 s38, s33, 0xff
    s_add_u32 s38, s38, s37
    s_bfe_u32 s49, s33, 0xc0008
    s_sub_u32 s49, s49, s37
    s_lshr_b32 s43, s33, 20
    s_add_u32 s43, s43, s38
    s_and_b32 s40, s39, 31
    s_cmp_ge_u32 s40, s49
    s_cselect_b32 s48, s43, s38
    s_add_u32 s48, s48, s40
    s_lshl_b32 s48, s48, 15
    s_mov_b32 s22, 0x2800000
    s_mov_b32 s23, 0x20000
    s_mov_b32 s46, 0
    s_mul_i32 s40, s34, 3
    v_mul_u32_u24 v10, 1792, v3
    v_subrev_u32 v10, s40, v10
    v_sub_u32 v32, v28, v10
    v_sub_u32 v33, v29, v10
    v_sub_u32 v34, v30, v10
    v_sub_u32 v35, v31, v10
    s_mov_b32 s30, 32768
    s_mov_b32 m0, 0x20000
    s_mov_b32 s31, 0x20000
    s_lshl_b32 s70, s36, 8
    s_add_u32 s71, s70, 128
    s_lshr_b32 s72, s34, 0
    s_lshl_b32 s73, s36, 3
    s_add_u32 s72, s72, s73
    s_add_u32 s72, s72, 0x480000
    s_waitcnt lgkmcnt(0)
    s_load_dword s92, s[10:11], s70
    s_load_dword s93, s[10:11], s71
    s_load_dword s94, s[18:19], s72
    s_load_dword s95, s[12:13], 0
    s_mov_b64 s[20:21], s[6:7]
    s_mov_b64 s[28:29], s[4:5]
    buffer_load_dwordx4 v32, s[28:31], 0 offen offset:0 lds
    buffer_load_dwordx4 v33, s[28:31], 0 offen offset:1024 lds
    buffer_load_dwordx4 v34, s[28:31], 0 offen offset:2048 lds
    buffer_load_dwordx4 v35, s[28:31], 0 offen offset:3072 lds
L_k1:
    s_lshl_b32 m0, s46, 12
    s_add_u32 s46, s46, 1
    buffer_load_dwordx4 v28, s[20:23], s48 offen offset:0 nt lds
    buffer_load_dwordx4 v29, s[20:23], s48 offen offset:1024 nt lds
    buffer_load_dwordx4 v30, s[20:23], s48 offen offset:2048 nt lds
    buffer_load_dwordx4 v31, s[20:23], s48 offen offset:3072 nt lds
    s_mul_i32 s40, s46, s45
    s_add_u32 s40, s40, s39
    s_and_b32 s40, s40, 31
    s_cmp_ge_u32 s40, s49
    s_cselect_b32 s48, s43, s38
    s_add_u32 s48, s48, s40
    s_lshl_b32 s48, s48, 15
    s_cmp_lt_u32 s46, 6
    s_cbranch_scc1 L_k1
    v_lshlrev_b32 v8, 1, v3
    v_xor_b32 v8, v8, v2
    v_lshl_add_u32 v24, v8, 4, v9
    v_xor_b32 v25, 128, v24
    v_add_u32 v25, 7168, v25
    v_add_u32 v26, 14336, v24
    v_add_u32 v27, 14336, v25
    v_mov_b32 v14, 0
    v_mov_b32 v11, 0x24400
    s_mov_b32 s47, 0x800000
    s_sub_u32 s42, 33, s35
    s_barrier
L_k2:
    s_lshl_b32 m0, s46, 12
    s_add_u32 s46, s46, 1
    buffer_load_dwordx4 v28, s[20:23], s48 offen offset:0 nt lds
    buffer_load_dwordx4 v29, s[20:23], s48 offen offset:1024 nt lds
    buffer_load_dwordx4 v30, s[20:23], s48 offen offset:2048 nt lds
    buffer_load_dwordx4 v31, s[20:23], s48 offen offset:3072 nt lds
    s_mul_i32 s40, s46, s45
    s_add_u32 s40, s40, s39
    s_and_b32 s40, s40, 31
    s_cmp_ge_u32 s40, s49
    s_cselect_b32 s48, s43, s38
    s_add_u32 s48, s48, s40
    s_lshl_b32 s48, s48, 15
    v_add_u32 v14, 1, v14
    s_waitcnt vmcnt(22)
    ds_write_b32 v11, v14 offset:8
    s_cmp_lt_u32 s46, s35
    s_cbranch_scc1 L_k2
    s_mov_b64 s[20:21], s[8:9]
    s_mov_b32 s46, 0
    s_and_b32 s40, s39, 31
    s_cmp_ge_u32 s40, s49
    s_cselect_b32 s48, s43, s38
    s_add_u32 s48, s48, s40
    s_lshl_b32 s48, s48, 15
    v_mov_b32 v12, 0x24410
L_v:
    s_and_b32 s40, s46, 7
    s_cbranch_scc1 L_vgo
L_vchk:
    ds_read_b32 v8, v12
    s_waitcnt lgkmcnt(0)
    v_readfirstlane_b32 s40, v8
    s_cmp_ge_u32 s40, 8
    s_cbranch_scc1 L_vchk_ok
    s_sub_u32 s47, s47, 1
    s_cmp_gt_i32 s47, 0
    s_cbranch_scc1 L_vchk
L_vchk_ok:
    v_add_u32 v12, 4, v12
L_vgo:
    s_lshl_b32 m0, s46, 12
    s_add_u32 s46, s46, 1
    buffer_load_dwordx4 v24, s[20:23], s48 offen offset:0 nt lds
    buffer_load_dwordx4 v25, s[20:23], s48 offen offset:1024 nt lds
    buffer_load_dwordx4 v26, s[20:23], s48 offen offset:2048 nt lds
    buffer_load_dwordx4 v27, s[20:23], s48 offen offset:3072 nt lds
    s_mul_i32 s40, s46, s45
    s_add_u32 s40, s40, s39
    s_and_b32 s40, s40, 31
    s_cmp_ge_u32 s40, s49
    s_cselect_b32 s48, s43, s38
    s_add_u32 s48, s48, s40
    s_lshl_b32 s48, s48, 15
    s_cmp_eq_u32 s46, 6
    s_cselect_b32 s40, s42, 1
    v_add_u32 v14, s40, v14
    s_waitcnt vmcnt(22)
    ds_write_b32 v11, v14 offset:8
    s_cmp_lt_u32 s46, s35
    s_cbranch_scc1 L_v
    v_add_u32 v14, 2, v14
    s_waitcnt vmcnt(16)
    ds_write_b32 v11, v14 offset:8
    v_add_u32 v14, 2, v14
    s_waitcnt vmcnt(8)
    ds_write_b32 v11, v14 offset:8
    v_mov_b32 v14, 64
    s_waitcnt vmcnt(0)
    ds_write_b32 v11, v14 offset:8
    s_endpgm
L_w1:
    s_branch L_common
L_w8:
L_w9:
L_common:
    v_and_b32 v1, 63, v0
    s_lshl_b32 s50, s34, 5
    s_add_u32 s50, s50, s36
    s_lshl_b32 s34, s34, 8
    v_and_b32 v2, 15, v1
    v_lshrrev_b32 v3, 4, v1
    v_mov_b32 v11, 0x24400
    s_mov_b32 s47, 0x800000
    s_getreg_b32 s51, hwreg(HW_REG_XCC_ID, 0, 4)
    s_waitcnt lgkmcnt(0)
    s_mov_b64 s[24:25], s[18:19]
    s_mov_b32 s26, 0x10000000
    s_mov_b32 s27, 0x20000
    s_mov_b64 s[28:29], s[14:15]
    s_mov_b32 s30, 0x8000
    s_mov_b32 s31, 0x20000
    s_sub_u32 s32, s32, 2
    s_cbranch_scc1 L_merge
    v_lshrrev_b32 v12, 2, v2
    s_lshr_b32 s40, s34, 0
    s_lshl_b32 s41, s32, 3
    s_add_u32 s40, s40, s41
    s_add_u32 s33, s40, 0x480000
    v_lshlrev_b32 v37, 6, v12
    buffer_load_dword v38, v37, s[24:27], s33 offen
    v_mul_u32_u24 v4, s45, v1
    v_add_u32 v4, s39, v4
    v_and_b32 v4, 31, v4
    v_cmp_gt_u32 vcc, s35, v4
    v_add_u32 v4, s37, v4
    v_add_u32 v8, 4294966812, v4
    v_add_u32 v9, 4294966610, v4
    v_add_u32 v10, 4294966435, v4
    v_med3_i32 v8, v8, 0, 1
    v_med3_i32 v9, v9, 0, 1
    v_med3_i32 v10, v10, 0, 1
    v_add3_u32 v7, v8, v9, v10
    v_mul_u32_u24 v8, 229, v8
    v_mul_u32_u24 v9, 202, v9
    v_mul_u32_u24 v10, 175, v10
    v_add3_u32 v5, v8, v9, v10
    v_sub_u32 v5, v4, v5
    s_movk_i32 s40, 256
    v_cmp_gt_u32 s[54:55], s40, v4
    v_lshlrev_b32 v9, v7, 1
    v_lshlrev_b32 v16, v12, 1
    v_cndmask_b32 v9, v9, 15, s[54:55]
    v_mul_u32_u24 v17, 433, v12
    v_lshl_or_b32 v5, v5, 8, v9
    v_cndmask_b32 v5, 0, v5, vcc
    v_lshl_add_u32 v17, v3, 2, v17
    v_sub_u32 v17, 7759, v17
    s_lshl_b32 s40, s36, 2
    s_cmp_ge_u32 s36, 16
    s_mov_b32 s54, 0xffffffff
    s_mov_b32 s55, 0x31111111
    s_cselect_b32 s54, 0x44622222, s54
    s_cselect_b32 s55, 0x88888c44, s55
    s_lshr_b64 s[54:55], s[54:55], s40
    s_mov_b32 s44, s54
    v_lshlrev_b32 v18, 6, v2
    v_lshl_add_u32 v21, v3, 4, v18
    v_and_b32 v8, s44, v16
    v_cmp_ne_u32 s[52:53], 0, v8
    s_lshl_b32 s42, s50, 3
    s_add_u32 s42, s42, s32
    s_lshl_b32 s48, s42, 8
    s_add_u32 s48, s48, 0x400000
    s_lshl_b32 s42, s42, 10
    s_mov_b32 s64, 0x07060500
    s_mov_b32 s65, 0x07060501
    s_mov_b32 s66, 0x07060502
    s_mov_b32 s67, 0x07060503
    v_xor_b32 v8, v2, v3
    v_lshlrev_b32 v9, 8, v2
    v_lshl_add_u32 v8, v8, 4, v9
    s_lshl_b32 s40, s32, 12
    v_xor_b32 v9, 0, v8
    v_add_u32 v24, s40, v9
    v_add_u32 v116, 0x20000, v9
    v_xor_b32 v9, 64, v8
    v_add_u32 v25, s40, v9
    v_add_u32 v117, 0x20000, v9
    v_xor_b32 v9, 128, v8
    v_add_u32 v26, s40, v9
    v_add_u32 v118, 0x20000, v9
    v_xor_b32 v9, 192, v8
    v_add_u32 v27, s40, v9
    v_add_u32 v119, 0x20000, v9
    v_mov_b32 v19, 1
    v_mov_b32 v20, 0xf149f2ca
    v_mov_b32 v14, v20
    v_lshlrev_b32 v6, 4, v2
    s_mov_b32 s46, s32
    s_mov_b32 s45, 0x3e0293ee
    s_add_u32 s40, s32, 24
    s_cmp_ge_u32 s40, s35
    s_cbranch_scc0 L_nozero
    v_mov_b32 v104, 0
    v_mov_b32 v105, 0
    v_mov_b32 v106, 0
    v_mov_b32 v107, 0
    v_add_u32 v8, 0x10000, v24
    ds_write_b128 v8, v[104:107] offset:32768
    v_add_u32 v8, 0x10000, v25
    ds_write_b128 v8, v[104:107] offset:32768
    v_add_u32 v8, 0x10000, v26
    ds_write_b128 v8, v[104:107] offset:32768
    v_add_u32 v8, 0x10000, v27
    ds_write_b128 v8, v[104:107] offset:32768
L_nozero:
    s_barrier
L_prog0:
    s_sleep 1
    ds_read_b32 v8, v11 offset:8
    s_waitcnt lgkmcnt(0)
    v_cmp_ge_u32 vcc, s46, v8
    s_cbranch_vccnz L_prog0
    ds_read_b128 v[120:123], v116
    ds_read_b128 v[124:127], v117
    ds_read_b128 v[128:131], v118
    ds_read_b128 v[132:135], v119
    s_waitcnt lgkmcnt(0)
    ds_read_b128 v[104:107], v24 offset:0
    ds_read_b128 v[108:111], v25 offset:0
    ds_read_b128 v[112:115], v26 offset:0
    ds_read_b128 v[116:119], v27 offset:0
    v_readlane_b32 s40, v5, s46
    s_add_u32 s46, s46, 8
    s_nop 0
    v_and_b32 v8, s40, v16
    s_lshr_b32 s40, s40, 4
    s_and_b32 s40, s40, 0xfffffff0
    v_cmp_ne_u32 s[54:55], 0, v8
    v_subrev_u32 v18, s40, v17
    s_waitcnt lgkmcnt(3)
    v_mfma_f32_16x16x32_bf16 v[136:139], v[104:107], v[120:123], 0
    s_waitcnt lgkmcnt(2)
    v_mfma_f32_16x16x32_bf16 v[136:139], v[108:111], v[124:127], v[136:139]
    s_waitcnt lgkmcnt(1)
    v_mfma_f32_16x16x32_bf16 v[136:139], v[112:115], v[128:131], v[136:139]
    s_waitcnt lgkmcnt(0)
    v_mfma_f32_16x16x32_bf16 v[136:139], v[116:119], v[132:135], v[136:139]
    v_cndmask_b32 v18, -1, v18, s[54:55]
    s_mov_b64 exec, 1
    ds_add_u32 v11, v19 offset:16
    s_mov_b64 exec, -1
    v_cmp_lt_i32 s[54:55], 0, v18
    v_cmp_lt_i32 s[56:57], 1, v18
    v_cmp_lt_i32 s[58:59], 2, v18
    v_cmp_lt_i32 s[60:61], 3, v18
    v_cndmask_b32 v136, v20, v136, s[54:55]
    v_cndmask_b32 v137, v20, v137, s[56:57]
    v_cndmask_b32 v138, v20, v138, s[58:59]
    v_cndmask_b32 v139, v20, v139, s[60:61]
    v_max3_f32 v14, v14, v136, v137
    v_max3_f32 v14, v14, v138, v139
    s_branch L_skip5
L_w5:
    s_branch L_common
L_skip5:
L_prog1:
    s_sleep 1
    ds_read_b32 v8, v11 offset:8
    s_waitcnt lgkmcnt(0)
    v_cmp_ge_u32 vcc, s46, v8
    s_cbranch_vccnz L_prog1
    ds_read_b128 v[104:107], v24 offset:32768
    ds_read_b128 v[108:111], v25 offset:32768
    ds_read_b128 v[112:115], v26 offset:32768
    ds_read_b128 v[116:119], v27 offset:32768
    v_readlane_b32 s40, v5, s46
    s_add_u32 s46, s46, 8
    v_add_u32 v24, 0x10000, v24
    v_add_u32 v25, 0x10000, v25
    v_add_u32 v26, 0x10000, v26
    v_add_u32 v27, 0x10000, v27
    v_and_b32 v8, s40, v16
    s_lshr_b32 s40, s40, 4
    s_and_b32 s40, s40, 0xfffffff0
    v_cmp_ne_u32 s[54:55], 0, v8
    v_subrev_u32 v18, s40, v17
    s_waitcnt lgkmcnt(3)
    v_mfma_f32_16x16x32_bf16 v[140:143], v[104:107], v[120:123], 0
    s_waitcnt lgkmcnt(2)
    v_mfma_f32_16x16x32_bf16 v[140:143], v[108:111], v[124:127], v[140:143]
    s_waitcnt lgkmcnt(1)
    v_mfma_f32_16x16x32_bf16 v[140:143], v[112:115], v[128:131], v[140:143]
    s_waitcnt lgkmcnt(0)
    v_mfma_f32_16x16x32_bf16 v[140:143], v[116:119], v[132:135], v[140:143]
    v_cndmask_b32 v18, -1, v18, s[54:55]
    s_mov_b64 exec, 1
    ds_add_u32 v11, v19 offset:20
    s_mov_b64 exec, -1
    v_cmp_lt_i32 s[54:55], 0, v18
    v_cmp_lt_i32 s[56:57], 1, v18
    v_cmp_lt_i32 s[58:59], 2, v18
    v_cmp_lt_i32 s[60:61], 3, v18
    v_cndmask_b32 v140, v20, v140, s[54:55]
    v_cndmask_b32 v141, v20, v141, s[56:57]
    v_cndmask_b32 v142, v20, v142, s[58:59]
    v_cndmask_b32 v143, v20, v143, s[60:61]
    v_max3_f32 v14, v14, v140, v141
    v_max3_f32 v14, v14, v142, v143
L_prog2:
    s_sleep 1
    ds_read_b32 v8, v11 offset:8
    s_waitcnt lgkmcnt(0)
    v_cmp_ge_u32 vcc, s46, v8
    s_cbranch_vccnz L_prog2
    ds_read_b128 v[104:107], v24 offset:0
    ds_read_b128 v[108:111], v25 offset:0
    ds_read_b128 v[112:115], v26 offset:0
    ds_read_b128 v[116:119], v27 offset:0
    v_readlane_b32 s40, v5, s46
    s_add_u32 s46, s46, 8
    s_nop 0
    v_and_b32 v8, s40, v16
    s_lshr_b32 s40, s40, 4
    s_and_b32 s40, s40, 0xfffffff0
    v_cmp_ne_u32 s[54:55], 0, v8
    v_subrev_u32 v18, s40, v17
    s_waitcnt lgkmcnt(3)
    v_mfma_f32_16x16x32_bf16 v[144:147], v[104:107], v[120:123], 0
    s_waitcnt lgkmcnt(2)
    v_mfma_f32_16x16x32_bf16 v[144:147], v[108:111], v[124:127], v[144:147]
    s_waitcnt lgkmcnt(1)
    v_mfma_f32_16x16x32_bf16 v[144:147], v[112:115], v[128:131], v[144:147]
    s_waitcnt lgkmcnt(0)
    v_mfma_f32_16x16x32_bf16 v[144:147], v[116:119], v[132:135], v[144:147]
    v_cndmask_b32 v18, -1, v18, s[54:55]
    s_mov_b64 exec, 1
    ds_add_u32 v11, v19 offset:24
    s_mov_b64 exec, -1
    v_cmp_lt_i32 s[54:55], 0, v18
    v_cmp_lt_i32 s[56:57], 1, v18
    v_cmp_lt_i32 s[58:59], 2, v18
    v_cmp_lt_i32 s[60:61], 3, v18
    v_cndmask_b32 v144, v20, v144, s[54:55]
    v_cndmask_b32 v145, v20, v145, s[56:57]
    v_cndmask_b32 v146, v20, v146, s[58:59]
    v_cndmask_b32 v147, v20, v147, s[60:61]
    v_max3_f32 v14, v14, v144, v145
    v_max3_f32 v14, v14, v146, v147
    buffer_load_dword v37, v37, s[24:27], s33 offen offset:4 sc1
L_prog3:
    s_sleep 1
    ds_read_b32 v8, v11 offset:8
    s_waitcnt lgkmcnt(0)
    v_cmp_ge_u32 vcc, s46, v8
    s_cbranch_vccnz L_prog3
    ds_read_b128 v[104:107], v24 offset:32768
    ds_read_b128 v[108:111], v25 offset:32768
    ds_read_b128 v[112:115], v26 offset:32768
    ds_read_b128 v[116:119], v27 offset:32768
    v_readlane_b32 s40, v5, s46
    s_add_u32 s46, s46, 8
    s_nop 0
    v_and_b32 v8, s40, v16
    s_lshr_b32 s40, s40, 4
    s_and_b32 s40, s40, 0xfffffff0
    v_cmp_ne_u32 s[54:55], 0, v8
    v_subrev_u32 v18, s40, v17
    s_waitcnt lgkmcnt(3)
    v_mfma_f32_16x16x32_bf16 v[148:151], v[104:107], v[120:123], 0
    s_waitcnt lgkmcnt(2)
    v_mfma_f32_16x16x32_bf16 v[148:151], v[108:111], v[124:127], v[148:151]
    s_waitcnt lgkmcnt(1)
    v_mfma_f32_16x16x32_bf16 v[148:151], v[112:115], v[128:131], v[148:151]
    s_waitcnt lgkmcnt(0)
    v_mfma_f32_16x16x32_bf16 v[148:151], v[116:119], v[132:135], v[148:151]
    v_cndmask_b32 v18, -1, v18, s[54:55]
    s_mov_b64 exec, 1
    ds_add_u32 v11, v19 offset:28
    s_mov_b64 exec, -1
    v_cmp_lt_i32 s[54:55], 0, v18
    v_cmp_lt_i32 s[56:57], 1, v18
    v_cmp_lt_i32 s[58:59], 2, v18
    v_cmp_lt_i32 s[60:61], 3, v18
    v_cndmask_b32 v148, v20, v148, s[54:55]
    v_cndmask_b32 v149, v20, v149, s[56:57]
    v_cndmask_b32 v150, v20, v150, s[58:59]
    v_cndmask_b32 v151, v20, v151, s[60:61]
    v_max3_f32 v14, v14, v148, v149
    v_max3_f32 v14, v14, v150, v151
    v_mov_b32 v8, v14
    s_nop 1
    v_permlane32_swap_b32 v8, v14
    s_nop 1
    v_max_f32 v14, v8, v14
    v_mov_b32 v8, v14
    s_nop 1
    v_permlane16_swap_b32 v8, v14
    s_nop 1
    v_max_f32 v14, v8, v14
    s_lshl_b32 s40, s32, 2
    v_lshlrev_b32 v22, 5, v2
    v_add_u32 v22, 0x24000, v22
    v_add_u32 v23, s40, v22
    ds_write_b32 v23, v14
    s_waitcnt lgkmcnt(0)
    s_mov_b64 exec, 1
    ds_add_u32 v11, v19 offset:0
    s_mov_b64 exec, -1
    s_branch L_skip6
L_w6:
    s_branch L_common
L_skip6:
L_sync1:
    ds_read_b32 v8, v11 offset:0
    s_waitcnt lgkmcnt(0)
    v_readfirstlane_b32 s40, v8
    s_and_b32 s41, s40, 0xffff
    s_cmp_ge_u32 s41, 9
    s_cbranch_scc1 L_sync1_ok
    s_sleep 1
    s_sub_u32 s47, s47, 1
    s_cmp_gt_i32 s47, 0
    s_cbranch_scc1 L_sync1
L_sync1_ok:
    ds_read_b128 v[104:107], v22
    ds_read_b128 v[108:111], v22 offset:16
    s_cmp_gt_u32 s40, 0xffff
    s_cbranch_scc1 L_slow
    s_waitcnt lgkmcnt(0)
    v_max3_f32 v14, v104, v105, v106
    v_max3_f32 v14, v14, v107, v108
    v_max3_f32 v14, v14, v109, v110
    v_max_f32 v14, v14, v111
    v_mul_f32 v14, s45, v14
    v_max_f32 v14, 0xe0ad78ec, v14
    v_fma_f32 v136, v136, s45, -v14
    v_fma_f32 v137, v137, s45, -v14
    v_fma_f32 v138, v138, s45, -v14
    v_fma_f32 v139, v139, s45, -v14
    v_fma_f32 v140, v140, s45, -v14
    v_fma_f32 v141, v141, s45, -v14
    v_fma_f32 v142, v142, s45, -v14
    v_fma_f32 v143, v143, s45, -v14
    v_fma_f32 v144, v144, s45, -v14
    v_fma_f32 v145, v145, s45, -v14
    v_fma_f32 v146, v146, s45, -v14
    v_fma_f32 v147, v147, s45, -v14
    v_fma_f32 v148, v148, s45, -v14
    v_fma_f32 v149, v149, s45, -v14
    v_fma_f32 v150, v150, s45, -v14
    v_fma_f32 v151, v151, s45, -v14
    v_exp_f32 v136, v136
    v_exp_f32 v137, v137
    v_exp_f32 v138, v138
    v_exp_f32 v139, v139
    v_exp_f32 v140, v140
    v_exp_f32 v141, v141
    v_exp_f32 v142, v142
    v_exp_f32 v143, v143
    v_exp_f32 v144, v144
    v_exp_f32 v145, v145
    v_exp_f32 v146, v146
    v_exp_f32 v147, v147
    v_exp_f32 v148, v148
    v_exp_f32 v149, v149
    v_exp_f32 v150, v150
    v_exp_f32 v151, v151
    s_lshr_b32 s40, s32, 1
    v_cvt_pk_bf16_f32 v104, v136, v137
    v_cvt_pk_bf16_f32 v105, v138, v139
    v_cvt_pk_bf16_f32 v106, v140, v141
    v_cvt_pk_bf16_f32 v107, v142, v143
    v_cvt_pk_bf16_f32 v108, v144, v145
    v_cvt_pk_bf16_f32 v109, v146, v147
    v_cvt_pk_bf16_f32 v110, v148, v149
    v_cvt_pk_bf16_f32 v111, v150, v151
    s_lshl_b32 s40, s40, 10
    s_and_b32 s41, s32, 1
    s_lshl_b32 s41, s41, 3
    s_add_u32 s40, s40, s41
    v_lshlrev_b32 v12, 4, v1
    v_add_u32 v12, 0x20000, v12
    v_add_u32 v13, s40, v12
    ds_write_b64 v13, v[104:105] offset:0
    ds_write_b64 v13, v[106:107] offset:4096
    ds_write_b64 v13, v[108:109] offset:8192
    ds_write_b64 v13, v[110:111] offset:12288
    v_add_f32 v15, v136, v137
    v_add_f32 v15, v15, v138
    v_add_f32 v15, v15, v139
    v_add_f32 v15, v15, v140
    v_add_f32 v15, v15, v141
    v_add_f32 v15, v15, v142
    v_add_f32 v15, v15, v143
    v_add_f32 v15, v15, v144
    v_add_f32 v15, v15, v145
    v_add_f32 v15, v15, v146
    v_add_f32 v15, v15, v147
    v_add_f32 v15, v15, v148
    v_add_f32 v15, v15, v149
    v_add_f32 v15, v15, v150
    v_add_f32 v15, v15, v151
    v_mov_b32 v8, v15
    s_nop 1
    v_permlane32_swap_b32 v8, v15
    s_nop 1
    v_add_f32 v15, v8, v15
    v_mov_b32 v8, v15
    s_nop 1
    v_permlane16_swap_b32 v8, v15
    s_nop 1
    v_add_f32 v15, v8, v15
    ds_write_b32 v23, v15 offset:512
    s_waitcnt lgkmcnt(0)
    s_mov_b64 exec, 1
    ds_add_u32 v11, v19 offset:4
    s_mov_b64 exec, -1
    s_branch L_skip7
L_w7:
    s_branch L_common
L_skip7:
L_sync2:
    ds_read_b32 v8, v11 offset:4
    s_waitcnt lgkmcnt(0)
    v_readfirstlane_b32 s40, v8
    s_cmp_ge_u32 s40, 8
    s_cbranch_scc1 L_sync2_ok
    s_sleep 1
    s_sub_u32 s47, s47, 1
    s_cmp_gt_i32 s47, 0
    s_cbranch_scc1 L_sync2
L_sync2_ok:
    ds_read_b128 v[104:107], v22 offset:512
    ds_read_b128 v[108:111], v22 offset:528
    ds_read_b128 v[40:43], v12 offset:0
    ds_read_b128 v[44:47], v12 offset:1024
    ds_read_b128 v[48:51], v12 offset:2048
    ds_read_b128 v[52:55], v12 offset:3072
    ds_read_b128 v[56:59], v12 offset:4096
    ds_read_b128 v[60:63], v12 offset:5120
    ds_read_b128 v[64:67], v12 offset:6144
    ds_read_b128 v[68:71], v12 offset:7168
    ds_read_b128 v[72:75], v12 offset:8192
    ds_read_b128 v[76:79], v12 offset:9216
    ds_read_b128 v[80:83], v12 offset:10240
    ds_read_b128 v[84:87], v12 offset:11264
    s_waitcnt vmcnt(0) lgkmcnt(12)
    v_add_u32 v38, 0x1010101, v38
    v_xor_b32 v37, s51, v37
    v_cmp_ne_u32 s[62:63], v37, v38
    v_add_f32 v106, v106, v104
    v_add_f32 v106, v106, v105
    v_add_f32 v106, v106, v107
    v_add_f32 v106, v106, v108
    v_add_f32 v106, v106, v109
    v_add_f32 v106, v106, v110
    v_add_f32 v106, v106, v111
    v_cndmask_b32 v8, 0, 1, s[62:63]
    v_mov_b32 v104, v14
    v_mov_b32 v105, v38
    v_xor_b32 v107, v8, v38
    s_and_b64 s[62:63], s[62:63], s[52:53]
    s_and_b64 exec, s[52:53], 0xffff
    buffer_store_dwordx4 v[104:107], v6, s[24:27], s48 offen
    s_add_u32 s48, s48, 0x200000
    s_and_b64 exec, exec, s[62:63]
    s_cbranch_execz L_mlnear
    buffer_store_dwordx4 v[104:107], v6, s[24:27], s48 offen sc1
L_mlnear:
    s_mov_b64 exec, -1
    s_add_u32 s48, s42, 0x200000
    s_waitcnt lgkmcnt(4)
    ds_read_b128 v[88:91], v12 offset:12288
    ds_read_b128 v[92:95], v12 offset:13312
    ds_read_b128 v[96:99], v12 offset:14336
    ds_read_b128 v[100:103], v12 offset:15360
    v_lshrrev_b32 v8, 2, v1
    v_and_b32 v9, 7, v8
    v_xor_b32 v9, s32, v9
    v_lshlrev_b32 v4, 8, v8
    v_lshl_add_u32 v4, v9, 5, v4
    v_and_b32 v8, 3, v1
    v_lshl_add_u32 v4, v8, 3, v4
    v_add_u32 v5, 0x10000, v4
L_pvw0:
    s_sleep 1
    ds_read_b32 v8, v11 offset:8
    s_waitcnt lgkmcnt(0)
    v_cmp_gt_u32 vcc, 42, v8
    s_cbranch_vccnz L_pvw0
    ds_read_b64_tr_b16 v[104:105], v4 offset:0
    ds_read_b64_tr_b16 v[106:107], v4 offset:4096
    ds_read_b64_tr_b16 v[108:109], v4 offset:8192
    ds_read_b64_tr_b16 v[110:111], v4 offset:12288
    ds_read_b64_tr_b16 v[112:113], v4 offset:16384
    ds_read_b64_tr_b16 v[114:115], v4 offset:20480
    ds_read_b64_tr_b16 v[116:117], v4 offset:24576
    ds_read_b64_tr_b16 v[118:119], v4 offset:28672
    ds_read_b64_tr_b16 v[120:121], v4 offset:32768
    ds_read_b64_tr_b16 v[122:123], v4 offset:36864
    s_waitcnt lgkmcnt(8)
    v_mfma_f32_16x16x32_bf16 v[152:155], v[104:107], v[40:43], 0
    s_waitcnt lgkmcnt(6)
    v_mfma_f32_16x16x32_bf16 v[152:155], v[108:111], v[44:47], v[152:155]
    s_waitcnt lgkmcnt(4)
    v_mfma_f32_16x16x32_bf16 v[152:155], v[112:115], v[48:51], v[152:155]
    s_waitcnt lgkmcnt(2)
    v_mfma_f32_16x16x32_bf16 v[152:155], v[116:119], v[52:55], v[152:155]
    s_waitcnt lgkmcnt(0)
    v_mfma_f32_16x16x32_bf16 v[152:155], v[120:123], v[56:59], v[152:155]
L_pvw1:
    s_sleep 1
    ds_read_b32 v8, v11 offset:8
    s_waitcnt lgkmcnt(0)
    v_cmp_gt_u32 vcc, 52, v8
    s_cbranch_vccnz L_pvw1
    ds_read_b64_tr_b16 v[124:125], v4 offset:40960
    ds_read_b64_tr_b16 v[126:127], v4 offset:45056
    ds_read_b64_tr_b16 v[128:129], v4 offset:49152
    ds_read_b64_tr_b16 v[130:131], v4 offset:53248
    ds_read_b64_tr_b16 v[132:133], v4 offset:57344
    ds_read_b64_tr_b16 v[134:135], v4 offset:61440
    ds_read_b64_tr_b16 v[104:105], v5 offset:0
    ds_read_b64_tr_b16 v[106:107], v5 offset:4096
    ds_read_b64_tr_b16 v[108:109], v5 offset:8192
    ds_read_b64_tr_b16 v[110:111], v5 offset:12288
    s_waitcnt lgkmcnt(8)
    v_mfma_f32_16x16x32_bf16 v[152:155], v[124:127], v[60:63], v[152:155]
    s_waitcnt lgkmcnt(6)
    v_mfma_f32_16x16x32_bf16 v[152:155], v[128:131], v[64:67], v[152:155]
    s_waitcnt lgkmcnt(4)
    v_mfma_f32_16x16x32_bf16 v[152:155], v[132:135], v[68:71], v[152:155]
    s_waitcnt lgkmcnt(2)
    v_mfma_f32_16x16x32_bf16 v[152:155], v[104:107], v[72:75], v[152:155]
    s_waitcnt lgkmcnt(0)
    v_mfma_f32_16x16x32_bf16 v[152:155], v[108:111], v[76:79], v[152:155]
L_pvw2:
    s_sleep 1
    ds_read_b32 v8, v11 offset:8
    s_waitcnt lgkmcnt(0)
    v_cmp_gt_u32 vcc, 58, v8
    s_cbranch_vccnz L_pvw2
    ds_read_b64_tr_b16 v[112:113], v5 offset:16384
    ds_read_b64_tr_b16 v[114:115], v5 offset:20480
    ds_read_b64_tr_b16 v[116:117], v5 offset:24576
    ds_read_b64_tr_b16 v[118:119], v5 offset:28672
    ds_read_b64_tr_b16 v[120:121], v5 offset:32768
    ds_read_b64_tr_b16 v[122:123], v5 offset:36864
    s_waitcnt lgkmcnt(4)
    v_mfma_f32_16x16x32_bf16 v[152:155], v[112:115], v[80:83], v[152:155]
    s_waitcnt lgkmcnt(2)
    v_mfma_f32_16x16x32_bf16 v[152:155], v[116:119], v[84:87], v[152:155]
    s_waitcnt lgkmcnt(0)
    v_mfma_f32_16x16x32_bf16 v[152:155], v[120:123], v[88:91], v[152:155]
L_pvw3:
    ds_read_b32 v8, v11 offset:8
    ds_read_b64_tr_b16 v[124:125], v5 offset:40960
    ds_read_b64_tr_b16 v[126:127], v5 offset:45056
    s_waitcnt lgkmcnt(0)
    v_cmp_gt_u32 vcc, 60, v8
    s_cbranch_vccnz L_pvw3
    v_mfma_f32_16x16x32_bf16 v[152:155], v[124:127], v[92:95], v[152:155]
L_pvw4:
    ds_read_b32 v8, v11 offset:8
    ds_read_b64_tr_b16 v[128:129], v5 offset:49152
    ds_read_b64_tr_b16 v[130:131], v5 offset:53248
    s_waitcnt lgkmcnt(0)
    v_cmp_gt_u32 vcc, 62, v8
    s_cbranch_vccnz L_pvw4
    v_mfma_f32_16x16x32_bf16 v[152:155], v[128:131], v[96:99], v[152:155]
L_pvw5:
    ds_read_b32 v8, v11 offset:8
    ds_read_b64_tr_b16 v[132:133], v5 offset:57344
    ds_read_b64_tr_b16 v[134:135], v5 offset:61440
    s_waitcnt lgkmcnt(0)
    v_cmp_gt_u32 vcc, 64, v8
    s_cbranch_vccnz L_pvw5
    v_mfma_f32_16x16x32_bf16 v[152:155], v[132:135], v[100:103], v[152:155]
    s_mov_b64 exec, s[52:53]
    s_nop 6
    v_perm_b32 v152, v152, v38, s64
    v_perm_b32 v153, v153, v38, s65
    v_perm_b32 v154, v154, v38, s66
    v_perm_b32 v155, v155, v38, s67
    buffer_store_dwordx4 v[152:155], v21, s[24:27], s42 offen
    s_mov_b64 exec, s[62:63]
    s_cbranch_execz L_onear
    buffer_store_dwordx4 v[152:155], v21, s[24:27], s48 offen sc1
L_onear:
L_end:
    s_endpgm
L_w2:
    s_branch L_common
L_merge:
    v_mov_b32 v104, 0
    v_lshl_add_u32 v8, v2, 2, v11
    ds_write_b32 v8, v104
    s_lshl_b32 s42, s50, 3
    s_add_u32 s42, s42, 0x480000
    buffer_load_dword v38, v104, s[24:27], s42 offen
    v_lshlrev_b32 v12, 4, v1
    v_add_u32 v13, 4096, v12
    v_and_b32 v14, 3, v1
    v_lshlrev_b32 v15, 2, v14
    s_mov_b64 s[20:21], s[10:11]
    s_mov_b32 s22, 0x2000
    s_mov_b32 s23, 0x20000
    buffer_load_dwordx4 v[40:43], v12, s[20:23], 0 offen offset:0
    buffer_load_dwordx4 v[44:47], v12, s[20:23], 0 offen offset:1024
    buffer_load_dwordx4 v[48:51], v12, s[20:23], 0 offen offset:2048
    buffer_load_dwordx4 v[52:55], v12, s[20:23], 0 offen offset:3072
    buffer_load_dwordx4 v[56:59], v13, s[20:23], 0 offen offset:0
    buffer_load_dwordx4 v[60:63], v13, s[20:23], 0 offen offset:1024
    buffer_load_dwordx4 v[64:67], v13, s[20:23], 0 offen offset:2048
    buffer_load_dwordx4 v[68:71], v13, s[20:23], 0 offen offset:3072
    s_mov_b64 s[20:21], s[12:13]
    s_mov_b32 s22, 0x10
    s_mov_b32 s23, 0x20000
    buffer_load_dword v15, v15, s[20:23], 0 offen
    s_waitcnt lgkmcnt(0)
    s_barrier
    s_lshr_b32 s33, s36, 3
    s_and_b32 s46, s36, 7
    s_lshl_b32 s40, s33, 3
    s_lshr_b32 s35, 0x120d0700, s40
    s_and_b32 s35, s35, 0xff
    s_lshr_b32 s38, 0x1f1a150f, s40
    s_and_b32 s38, s38, 0xff
    s_lshl_b32 s40, s46, 2
    s_add_u32 s40, s40, s33
    s_lshl_b32 s41, s34, 2
    s_add_u32 s40, s40, s41
    s_lshl_b32 s41, s40, 8
    v_lshlrev_b32 v9, 4, v2
    v_add_u32 v9, s41, v9
    s_lshl_b32 s41, s40, 6
    s_add_u32 s41, s41, 0x400000
    v_lshrrev_b32 v12, 2, v2
    v_lshlrev_b32 v10, 4, v12
    v_add_u32 v10, s41, v10
    v_add_u32 v8, 0, v3
    v_cmp_ge_u32 s[4:5], s38, v8
    v_lshl_add_u32 v120, v8, 13, v9
    v_lshl_add_u32 v128, v8, 11, v10
    v_add_u32 v8, 4, v3
    v_cmp_ge_u32 s[6:7], s38, v8
    v_lshl_add_u32 v121, v8, 13, v9
    v_lshl_add_u32 v129, v8, 11, v10
    v_add_u32 v8, 8, v3
    v_add_u32 v8, s35, v8
    v_cmp_ge_u32 s[8:9], s38, v8
    v_lshl_add_u32 v122, v8, 13, v9
    v_lshl_add_u32 v130, v8, 11, v10
    v_add_u32 v8, 12, v3
    v_add_u32 v8, s35, v8
    v_cmp_ge_u32 s[10:11], s38, v8
    v_lshl_add_u32 v123, v8, 13, v9
    v_lshl_add_u32 v131, v8, 11, v10
    s_lshl_b32 s40, s33, 13
    s_lshl_b32 s41, s34, 2
    s_add_u32 s40, s40, s41
    s_lshl_b32 s41, s46, 5
    s_add_u32 s40, s40, s41
    v_lshlrev_b32 v7, 8, v12
    v_and_b32 v8, 3, v1
    v_lshl_add_u32 v7, v8, 3, v7
    v_lshl_add_u32 v7, v3, 1, v7
    v_add_u32 v7, s40, v7
    v_lshlrev_b32 v112, 2, v1
    v_add_u32 v113, 1, v112
    v_add_u32 v114, 2, v112
    v_add_u32 v115, 3, v112
    v_mul_u32_u24 v14, 433, v14
    v_sub_u32 v14, 7759, v14
    s_waitcnt vmcnt(0)
    v_xor_b32 v9, v15, v14
    v_xor_b32 v40, v40, v112
    v_xor_b32 v41, v41, v113
    v_xor_b32 v42, v42, v114
    v_xor_b32 v43, v43, v115
    v_or3_b32 v9, v9, v40, v41
    v_or3_b32 v9, v9, v42, v43
    v_xor_b32 v48, v48, v112
    v_xor_b32 v49, v49, v113
    v_xor_b32 v50, v50, v114
    v_xor_b32 v51, v51, v115
    v_or3_b32 v9, v9, v48, v49
    v_or3_b32 v9, v9, v50, v51
    v_xor_b32 v56, v56, v112
    v_xor_b32 v57, v57, v113
    v_xor_b32 v58, v58, v114
    v_xor_b32 v59, v59, v115
    v_or3_b32 v9, v9, v56, v57
    v_or3_b32 v9, v9, v58, v59
    v_xor_b32 v64, v64, v112
    v_xor_b32 v65, v65, v113
    v_xor_b32 v66, v66, v114
    v_xor_b32 v67, v67, v115
    v_or3_b32 v9, v9, v64, v65
    v_or3_b32 v9, v9, v66, v67
    v_add_u32 v112, 256, v112
    v_add_u32 v113, 256, v113
    v_add_u32 v114, 256, v114
    v_add_u32 v115, 256, v115
    v_xor_b32 v44, v44, v112
    v_xor_b32 v45, v45, v113
    v_xor_b32 v46, v46, v114
    v_xor_b32 v47, v47, v115
    v_or3_b32 v9, v9, v44, v45
    v_or3_b32 v9, v9, v46, v47
    v_add_u32 v112, 256, v112
    v_add_u32 v113, 256, v113
    v_add_u32 v114, 256, v114
    v_add_u32 v115, 256, v115
    v_xor_b32 v52, v52, v112
    v_xor_b32 v53, v53, v113
    v_xor_b32 v54, v54, v114
    v_xor_b32 v55, v55, v115
    v_or3_b32 v9, v9, v52, v53
    v_or3_b32 v9, v9, v54, v55
    v_add_u32 v112, 256, v112
    v_add_u32 v113, 256, v113
    v_add_u32 v114, 256, v114
    v_add_u32 v115, 256, v115
    v_xor_b32 v60, v60, v112
    v_xor_b32 v61, v61, v113
    v_xor_b32 v62, v62, v114
    v_xor_b32 v63, v63, v115
    v_or3_b32 v9, v9, v60, v61
    v_or3_b32 v9, v9, v62, v63
    v_add_u32 v112, 256, v112
    v_add_u32 v113, 256, v113
    v_add_u32 v114, 256, v114
    v_add_u32 v115, 256, v115
    v_xor_b32 v68, v68, v112
    v_xor_b32 v69, v69, v113
    v_xor_b32 v70, v70, v114
    v_xor_b32 v71, v71, v115
    v_or3_b32 v9, v9, v68, v69
    v_or3_b32 v9, v9, v70, v71
    v_cmp_ne_u32 vcc, 0, v9
    v_add_u32 v38, 0x1010101, v38
    s_mov_b32 s64, 0x0c0c0400
    s_cmp_lg_u64 vcc, 0
    s_cselect_b32 s40, 0x10001, 1
    v_mov_b32 v9, s40
    s_mov_b64 exec, 1
    ds_add_u32 v11, v9 offset:0
    s_mov_b64 exec, -1
    s_cbranch_scc1 L_end
    v_xor_b32 v9, s51, v38
    s_mov_b64 exec, 1
    buffer_store_dword v9, v104, s[24:27], s42 offen offset:4
    s_mov_b64 exec, -1
    s_mov_b32 s65, 0x0c040100
    s_mov_b32 s66, 0x04020100
    s_movk_i32 s67, 0xff00
    v_mov_b32 v9, 0xe0ad78ec
    s_mov_b64 s[52:53], s[4:5]
    s_mov_b64 s[54:55], s[6:7]
    s_mov_b64 s[56:57], s[8:9]
    v_mov_b32 v84, v9
    v_mov_b32 v86, 0
    v_mov_b32 v87, v38
    s_mov_b64 s[58:59], s[10:11]
    s_mov_b32 s48, 0
    s_mov_b32 s49, 0
    s_branch L_skip3
L_w3:
    s_branch L_common
L_skip3:
L_mdelay:
    s_sleep 1
    ds_read_b32 v8, v11 offset:8
    s_waitcnt lgkmcnt(0)
    v_cmp_gt_u32 vcc, 48, v8
    s_cbranch_vccnz L_mdelay
L_pollml:
    s_mov_b64 exec, s[52:53]
    buffer_load_dwordx4 v[72:75], v128, s[24:27], s48 offen sc1
    s_mov_b64 exec, s[54:55]
    buffer_load_dwordx4 v[76:79], v129, s[24:27], s48 offen sc1
    s_mov_b64 exec, s[56:57]
    buffer_load_dwordx4 v[80:83], v130, s[24:27], s48 offen sc1
    s_mov_b64 exec, s[58:59]
    buffer_load_dwordx4 v[84:87], v131, s[24:27], s48 offen sc1
    s_add_u32 s49, s49, 1
    s_cmp_ge_u32 s49, 4
    s_cselect_b32 s40, 0x200000, 0
    s_xor_b32 s48, s48, s40
    s_mov_b64 vcc, 0
    s_mov_b64 exec, s[52:53]
    s_waitcnt vmcnt(0)
    v_xor_b32 v8, v75, v38
    v_xor_b32 v9, v73, v38
    v_and_or_b32 v8, v8, -2, v9
    v_cmp_ne_u32 s[52:53], 0, v8
    s_mov_b64 exec, s[54:55]
    v_xor_b32 v8, v79, v38
    v_xor_b32 v9, v77, v38
    v_and_or_b32 v8, v8, -2, v9
    v_cmp_ne_u32 s[54:55], 0, v8
    s_or_b64 vcc, vcc, s[52:53]
    s_mov_b64 exec, s[56:57]
    v_xor_b32 v8, v83, v38
    v_xor_b32 v9, v81, v38
    v_and_or_b32 v8, v8, -2, v9
    v_cmp_ne_u32 s[56:57], 0, v8
    s_or_b64 vcc, vcc, s[54:55]
    s_mov_b64 exec, s[58:59]
    v_xor_b32 v8, v87, v38
    v_xor_b32 v9, v85, v38
    v_and_or_b32 v8, v8, -2, v9
    v_cmp_ne_u32 s[58:59], 0, v8
    s_or_b64 vcc, vcc, s[56:57]
    s_mov_b64 exec, -1
    s_or_b64 vcc, vcc, s[58:59]
    s_cbranch_scc0 L_mlok
    s_sleep 2
    s_sub_u32 s47, s47, 4
    s_cmp_gt_i32 s47, 0
    s_cbranch_scc1 L_pollml
L_mlok:
    v_xor_b32 v8, v75, v38
    v_lshl_add_u32 v120, v8, 21, v120
    v_xor_b32 v8, v79, v38
    v_lshl_add_u32 v121, v8, 21, v121
    v_xor_b32 v8, v83, v38
    v_lshl_add_u32 v122, v8, 21, v122
    v_xor_b32 v8, v87, v38
    v_lshl_add_u32 v123, v8, 21, v123
    v_max3_f32 v10, v72, v76, v80
    v_max_f32 v10, v10, v84
    v_mov_b32 v8, v10
    s_nop 1
    v_permlane32_swap_b32 v8, v10
    s_nop 1
    v_max_f32 v10, v8, v10
    v_mov_b32 v8, v10
    s_nop 1
    v_permlane16_swap_b32 v8, v10
    s_nop 1
    v_max_f32 v10, v8, v10
    v_sub_f32 v128, v72, v10
    v_sub_f32 v129, v76, v10
    v_sub_f32 v130, v80, v10
    v_sub_f32 v131, v84, v10
    v_exp_f32 v128, v128
    v_exp_f32 v129, v129
    v_exp_f32 v130, v130
    v_exp_f32 v131, v131
    v_mul_f32 v10, v128, v74
    v_fmac_f32 v10, v129, v78
    v_fmac_f32 v10, v130, v82
    v_fmac_f32 v10, v131, v86
    v_mov_b32 v8, v10
    s_nop 1
    v_permlane32_swap_b32 v8, v10
    s_nop 1
    v_add_f32 v10, v8, v10
    v_mov_b32 v8, v10
    s_nop 1
    v_permlane16_swap_b32 v8, v10
    s_nop 1
    v_add_f32 v10, v8, v10
    v_rcp_f32 v10, v10
    s_mov_b64 exec, 1
    buffer_store_dword v38, v104, s[24:27], s42 offen
    s_mov_b64 exec, -1
    v_mul_f32 v128, v128, v10
    v_mul_f32 v129, v129, v10
    v_mul_f32 v130, v130, v10
    v_mul_f32 v131, v131, v10
L_own:
    s_sleep 1
    ds_read_b32 v8, v11 offset:8
    s_waitcnt lgkmcnt(0)
    v_cmp_gt_u32 vcc, 58, v8
    s_cbranch_vccnz L_own
    s_max_i32 s47, s47, 0
    s_branch L_skip4
L_w4:
    s_branch L_common
L_skip4:
L_pollo:
    s_mov_b64 exec, s[4:5]
    buffer_load_dwordx4 v[40:43], v120, s[24:27], 0 offen sc1
    s_mov_b64 exec, s[6:7]
    buffer_load_dwordx4 v[44:47], v121, s[24:27], 0 offen sc1
    s_mov_b64 exec, s[8:9]
    buffer_load_dwordx4 v[48:51], v122, s[24:27], 0 offen sc1
    s_mov_b64 exec, s[10:11]
    buffer_load_dwordx4 v[52:55], v123, s[24:27], 0 offen sc1
    s_sub_u32 s47, s47, 1
    s_cbranch_scc1 L_ook
    s_mov_b64 exec, s[4:5]
    s_cbranch_execz L_oskip0
    s_waitcnt vmcnt(0)
    v_perm_b32 v8, v41, v40, s64
    v_perm_b32 v8, v42, v8, s65
    v_perm_b32 v8, v43, v8, s66
    v_cmpx_eq_u32 vcc, v8, v38
    v_and_b32 v40, s67, v40
    v_and_b32 v41, s67, v41
    v_and_b32 v42, s67, v42
    v_and_b32 v43, s67, v43
    v_pk_mul_f32 v[40:41], v[40:41], v[128:129] op_sel:[0,0] op_sel_hi:[1,0]
    v_pk_mul_f32 v[42:43], v[42:43], v[128:129] op_sel:[0,0] op_sel_hi:[1,0]
    s_andn2_b64 s[4:5], s[4:5], exec
L_oskip0:
    s_mov_b64 exec, s[6:7]
    s_cbranch_execz L_oskip1
    s_waitcnt vmcnt(0)
    v_perm_b32 v8, v45, v44, s64
    v_perm_b32 v8, v46, v8, s65
    v_perm_b32 v8, v47, v8, s66
    v_cmpx_eq_u32 vcc, v8, v38
    v_and_b32 v44, s67, v44
    v_and_b32 v45, s67, v45
    v_and_b32 v46, s67, v46
    v_and_b32 v47, s67, v47
    v_pk_mul_f32 v[44:45], v[44:45], v[128:129] op_sel:[0,1] op_sel_hi:[1,1]
    v_pk_mul_f32 v[46:47], v[46:47], v[128:129] op_sel:[0,1] op_sel_hi:[1,1]
    s_andn2_b64 s[6:7], s[6:7], exec
L_oskip1:
    s_mov_b64 exec, s[8:9]
    s_cbranch_execz L_oskip2
    s_waitcnt vmcnt(0)
    v_perm_b32 v8, v49, v48, s64
    v_perm_b32 v8, v50, v8, s65
    v_perm_b32 v8, v51, v8, s66
    v_cmpx_eq_u32 vcc, v8, v38
    v_and_b32 v48, s67, v48
    v_and_b32 v49, s67, v49
    v_and_b32 v50, s67, v50
    v_and_b32 v51, s67, v51
    v_pk_mul_f32 v[48:49], v[48:49], v[130:131] op_sel:[0,0] op_sel_hi:[1,0]
    v_pk_mul_f32 v[50:51], v[50:51], v[130:131] op_sel:[0,0] op_sel_hi:[1,0]
    s_andn2_b64 s[8:9], s[8:9], exec
L_oskip2:
    s_mov_b64 exec, s[10:11]
    s_cbranch_execz L_oskip3
    s_waitcnt vmcnt(0)
    v_perm_b32 v8, v53, v52, s64
    v_perm_b32 v8, v54, v8, s65
    v_perm_b32 v8, v55, v8, s66
    v_cmpx_eq_u32 vcc, v8, v38
    v_and_b32 v52, s67, v52
    v_and_b32 v53, s67, v53
    v_and_b32 v54, s67, v54
    v_and_b32 v55, s67, v55
    v_pk_mul_f32 v[52:53], v[52:53], v[130:131] op_sel:[0,1] op_sel_hi:[1,1]
    v_pk_mul_f32 v[54:55], v[54:55], v[130:131] op_sel:[0,1] op_sel_hi:[1,1]
    s_andn2_b64 s[10:11], s[10:11], exec
L_oskip3:
    s_or_b64 s[52:53], s[4:5], s[6:7]
    s_or_b64 vcc, s[8:9], s[10:11]
    s_or_b64 s[52:53], s[52:53], vcc
    s_cbranch_scc1 L_pollo
L_ook:
    s_mov_b64 exec, -1
    v_pk_add_f32 v[40:41], v[40:41], v[44:45]
    v_pk_add_f32 v[48:49], v[48:49], v[52:53]
    v_pk_add_f32 v[42:43], v[42:43], v[46:47]
    v_pk_add_f32 v[50:51], v[50:51], v[54:55]
    v_pk_add_f32 v[40:41], v[40:41], v[48:49]
    v_pk_add_f32 v[42:43], v[42:43], v[50:51]
    s_nop 1
    v_permlane32_swap_b32 v40, v42
    v_permlane32_swap_b32 v41, v43
    s_nop 0
    v_add_f32 v40, v40, v42
    v_add_f32 v41, v41, v43
    s_nop 1
    v_permlane16_swap_b32 v40, v41
    s_nop 1
    v_add_f32 v40, v40, v41
    v_cvt_pk_bf16_f32 v40, v40, v40
    buffer_store_short v40, v7, s[28:31], 0 offen
    s_endpgm
L_slow:
    s_cmp_ge_u32 s2, 32
    s_cbranch_scc1 L_end
L_drain:
    s_sleep 1
    ds_read_b32 v8, v11 offset:8
    s_waitcnt lgkmcnt(0)
    v_cmp_gt_u32 vcc, 64, v8
    s_cbranch_vccnz L_drain
    s_lshr_b32 s36, s2, 3
    s_and_b32 s34, s2, 7
    s_lshl_b32 s34, s34, 8
    s_lshl_b32 s40, s36, 2
    s_load_dword s35, s[12:13], s40
    s_lshl_b32 s40, s36, 11
    s_add_u32 s56, s10, s40
    s_addc_u32 s57, s11, 0
    s_mov_b64 s[20:21], s[4:5]
    s_mov_b32 s22, 0x8000
    s_mov_b32 s23, 0x20000
    v_and_b32 v8, 3, v1
    v_lshlrev_b32 v9, 8, v8
    v_lshl_add_u32 v9, v3, 4, v9
    s_lshl_b32 s40, s36, 13
    s_lshl_b32 s41, s34, 2
    s_add_u32 s38, s40, s41
    buffer_load_dwordx4 v[136:139], v9, s[20:23], s38 offen offset:0
    buffer_load_dwordx4 v[140:143], v9, s[20:23], s38 offen offset:64
    buffer_load_dwordx4 v[144:147], v9, s[20:23], s38 offen offset:128
    buffer_load_dwordx4 v[148:151], v9, s[20:23], s38 offen offset:192
    s_mov_b64 s[20:21], s[6:7]
    s_mov_b32 s22, 0x2800000
    s_mov_b32 s23, 0x20000
    s_mov_b64 s[60:61], s[8:9]
    s_mov_b32 s62, 0x2800000
    s_mov_b32 s63, 0x20000
    v_lshlrev_b32 v12, 11, v2
    v_lshl_add_u32 v12, v3, 4, v12
    v_add_u32 v12, s34, v12
    v_lshlrev_b32 v13, 13, v3
    v_lshl_add_u32 v13, v2, 4, v13
    v_add_u32 v13, s34, v13
    v_add_u32 v4, 4096, v13
    v_mov_b32 v104, 0
    v_mov_b32 v105, 0
    v_mov_b32 v106, 0
    v_mov_b32 v107, 0
    v_mov_b32 v108, 0
    v_mov_b32 v109, 0
    v_mov_b32 v110, 0
    v_mov_b32 v111, 0
    v_mov_b32 v112, 0
    v_mov_b32 v113, 0
    v_mov_b32 v114, 0
    v_mov_b32 v115, 0
    v_mov_b32 v116, 0
    v_mov_b32 v117, 0
    v_mov_b32 v118, 0
    v_mov_b32 v119, 0
    v_mov_b32 v120, 0
    v_mov_b32 v121, 0
    v_mov_b32 v122, 0
    v_mov_b32 v123, 0
    v_mov_b32 v124, 0
    v_mov_b32 v125, 0
    v_mov_b32 v126, 0
    v_mov_b32 v127, 0
    v_mov_b32 v128, 0
    v_mov_b32 v129, 0
    v_mov_b32 v130, 0
    v_mov_b32 v131, 0
    v_mov_b32 v132, 0
    v_mov_b32 v133, 0
    v_mov_b32 v134, 0
    v_mov_b32 v135, 0
    v_mov_b32 v14, 0xe0ad78ec
    v_mov_b32 v15, 0
    s_mov_b32 s64, 0x05040100
    s_mov_b32 s65, 0x07060302
    s_lshl_b32 s46, s32, 1
    s_waitcnt vmcnt(0) lgkmcnt(0)
    s_cmp_gt_i32 s35, 0
    s_cbranch_scc1 L_gctx
    v_mov_b32 v136, 0
    v_mov_b32 v137, 0
    v_mov_b32 v138, 0
    v_mov_b32 v139, 0
    v_mov_b32 v140, 0
    v_mov_b32 v141, 0
    v_mov_b32 v142, 0
    v_mov_b32 v143, 0
    v_mov_b32 v144, 0
    v_mov_b32 v145, 0
    v_mov_b32 v146, 0
    v_mov_b32 v147, 0
    v_mov_b32 v148, 0
    v_mov_b32 v149, 0
    v_mov_b32 v150, 0
    v_mov_b32 v151, 0
    s_movk_i32 s35, 8192
L_gctx:
    s_min_i32 s35, s35, 8192
    v_lshlrev_b32 v17, 2, v3
    v_sub_u32 v17, s35, v17
L_gloop:
    s_lshl_b32 s42, s46, 4
    s_cmp_ge_i32 s42, s35
    s_cbranch_scc1 L_gdone
    s_lshl_b32 s40, s46, 2
    s_load_dwordx2 s[54:55], s[56:57], s40
    v_subrev_u32 v18, s42, v17
    s_add_u32 s46, s46, 16
    s_waitcnt lgkmcnt(0)
    s_min_u32 s54, s54, 1280
    s_lshl_b32 s54, s54, 15
    s_min_u32 s55, s55, 1280
    s_lshl_b32 s55, s55, 15
    buffer_load_dwordx4 v[40:43], v12, s[20:23], s54 offen offset:0
    buffer_load_dwordx4 v[44:47], v12, s[20:23], s54 offen offset:64
    buffer_load_dwordx4 v[48:51], v12, s[20:23], s54 offen offset:128
    buffer_load_dwordx4 v[52:55], v12, s[20:23], s54 offen offset:192
    buffer_load_dwordx4 v[56:59], v12, s[20:23], s55 offen offset:0
    buffer_load_dwordx4 v[60:63], v12, s[20:23], s55 offen offset:64
    buffer_load_dwordx4 v[64:67], v12, s[20:23], s55 offen offset:128
    buffer_load_dwordx4 v[68:71], v12, s[20:23], s55 offen offset:192
    buffer_load_dwordx4 v[72:75], v13, s[60:63], s54 offen offset:0
    buffer_load_dwordx4 v[76:79], v13, s[60:63], s54 offen offset:2048
    buffer_load_dwordx4 v[80:83], v4, s[60:63], s54 offen offset:0
    buffer_load_dwordx4 v[84:87], v4, s[60:63], s54 offen offset:2048
    buffer_load_dwordx4 v[88:91], v13, s[60:63], s55 offen offset:0
    buffer_load_dwordx4 v[92:95], v13, s[60:63], s55 offen offset:2048
    buffer_load_dwordx4 v[96:99], v4, s[60:63], s55 offen offset:0
    buffer_load_dwordx4 v[100:103], v4, s[60:63], s55 offen offset:2048
    s_waitcnt vmcnt(8)
    v_mfma_f32_16x16x32_bf16 v[152:155], v[40:43], v[136:139], 0
    v_mfma_f32_16x16x32_bf16 v[156:159], v[56:59], v[136:139], 0
    v_mfma_f32_16x16x32_bf16 v[152:155], v[44:47], v[140:143], v[152:155]
    v_mfma_f32_16x16x32_bf16 v[156:159], v[60:63], v[140:143], v[156:159]
    v_mfma_f32_16x16x32_bf16 v[152:155], v[48:51], v[144:147], v[152:155]
    v_mfma_f32_16x16x32_bf16 v[156:159], v[64:67], v[144:147], v[156:159]
    v_mfma_f32_16x16x32_bf16 v[152:155], v[52:55], v[148:151], v[152:155]
    v_mfma_f32_16x16x32_bf16 v[156:159], v[68:71], v[148:151], v[156:159]
    s_nop 7
    v_cmp_lt_i32 vcc, 0, v18
    s_nop 1
    v_cndmask_b32 v152, v20, v152, vcc
    v_cmp_lt_i32 vcc, 1, v18
    s_nop 1
    v_cndmask_b32 v153, v20, v153, vcc
    v_cmp_lt_i32 vcc, 2, v18
    s_nop 1
    v_cndmask_b32 v154, v20, v154, vcc
    v_cmp_lt_i32 vcc, 3, v18
    s_nop 1
    v_cndmask_b32 v155, v20, v155, vcc
    v_cmp_lt_i32 vcc, 16, v18
    s_nop 1
    v_cndmask_b32 v156, v20, v156, vcc
    v_cmp_lt_i32 vcc, 17, v18
    s_nop 1
    v_cndmask_b32 v157, v20, v157, vcc
    v_cmp_lt_i32 vcc, 18, v18
    s_nop 1
    v_cndmask_b32 v158, v20, v158, vcc
    v_cmp_lt_i32 vcc, 19, v18
    s_nop 1
    v_cndmask_b32 v159, v20, v159, vcc
    v_max3_f32 v9, v152, v153, v154
    v_max3_f32 v9, v9, v155, v156
    v_max3_f32 v9, v9, v157, v158
    v_max_f32 v9, v9, v159
    v_mov_b32 v8, v9
    s_nop 1
    v_permlane32_swap_b32 v8, v9
    s_nop 1
    v_max_f32 v9, v8, v9
    v_mov_b32 v8, v9
    s_nop 1
    v_permlane16_swap_b32 v8, v9
    s_nop 1
    v_max_f32 v9, v8, v9
    v_mul_f32 v9, s45, v9
    v_max_f32 v9, v9, v14
    v_sub_f32 v10, v14, v9
    v_exp_f32 v10, v10
    v_mov_b32 v14, v9
    v_fma_f32 v152, v152, s45, -v14
    v_fma_f32 v153, v153, s45, -v14
    v_fma_f32 v154, v154, s45, -v14
    v_fma_f32 v155, v155, s45, -v14
    v_fma_f32 v156, v156, s45, -v14
    v_fma_f32 v157, v157, s45, -v14
    v_fma_f32 v158, v158, s45, -v14
    v_fma_f32 v159, v159, s45, -v14
    v_exp_f32 v152, v152
    v_exp_f32 v153, v153
    v_exp_f32 v154, v154
    v_exp_f32 v155, v155
    v_exp_f32 v156, v156
    v_exp_f32 v157, v157
    v_exp_f32 v158, v158
    v_exp_f32 v159, v159
    v_mul_f32 v15, v15, v10
    v_mul_f32 v104, v104, v10
    v_mul_f32 v105, v105, v10
    v_mul_f32 v106, v106, v10
    v_mul_f32 v107, v107, v10
    v_mul_f32 v108, v108, v10
    v_mul_f32 v109, v109, v10
    v_mul_f32 v110, v110, v10
    v_mul_f32 v111, v111, v10
    v_mul_f32 v112, v112, v10
    v_mul_f32 v113, v113, v10
    v_mul_f32 v114, v114, v10
    v_mul_f32 v115, v115, v10
    v_mul_f32 v116, v116, v10
    v_mul_f32 v117, v117, v10
    v_mul_f32 v118, v118, v10
    v_mul_f32 v119, v119, v10
    v_mul_f32 v120, v120, v10
    v_mul_f32 v121, v121, v10
    v_mul_f32 v122, v122, v10
    v_mul_f32 v123, v123, v10
    v_mul_f32 v124, v124, v10
    v_mul_f32 v125, v125, v10
    v_mul_f32 v126, v126, v10
    v_mul_f32 v127, v127, v10
    v_mul_f32 v128, v128, v10
    v_mul_f32 v129, v129, v10
    v_mul_f32 v130, v130, v10
    v_mul_f32 v131, v131, v10
    v_mul_f32 v132, v132, v10
    v_mul_f32 v133, v133, v10
    v_mul_f32 v134, v134, v10
    v_mul_f32 v135, v135, v10
    v_add_f32 v15, v15, v152
    v_add_f32 v15, v15, v153
    v_add_f32 v15, v15, v154
    v_add_f32 v15, v15, v155
    v_add_f32 v15, v15, v156
    v_add_f32 v15, v15, v157
    v_add_f32 v15, v15, v158
    v_add_f32 v15, v15, v159
    v_cvt_pk_bf16_f32 v24, v152, v153
    v_cvt_pk_bf16_f32 v25, v154, v155
    v_cvt_pk_bf16_f32 v26, v156, v157
    v_cvt_pk_bf16_f32 v27, v158, v159
    s_waitcnt vmcnt(0)
    v_perm_b32 v40, v76, v72, s64
    v_perm_b32 v41, v84, v80, s64
    v_perm_b32 v42, v92, v88, s64
    v_perm_b32 v43, v100, v96, s64
    v_perm_b32 v44, v76, v72, s65
    v_perm_b32 v45, v84, v80, s65
    v_perm_b32 v46, v92, v88, s65
    v_perm_b32 v47, v100, v96, s65
    v_perm_b32 v48, v77, v73, s64
    v_perm_b32 v49, v85, v81, s64
    v_perm_b32 v50, v93, v89, s64
    v_perm_b32 v51, v101, v97, s64
    v_perm_b32 v52, v77, v73, s65
    v_perm_b32 v53, v85, v81, s65
    v_perm_b32 v54, v93, v89, s65
    v_perm_b32 v55, v101, v97, s65
    v_perm_b32 v56, v78, v74, s64
    v_perm_b32 v57, v86, v82, s64
    v_perm_b32 v58, v94, v90, s64
    v_perm_b32 v59, v102, v98, s64
    v_perm_b32 v60, v78, v74, s65
    v_perm_b32 v61, v86, v82, s65
    v_perm_b32 v62, v94, v90, s65
    v_perm_b32 v63, v102, v98, s65
    v_perm_b32 v64, v79, v75, s64
    v_perm_b32 v65, v87, v83, s64
    v_perm_b32 v66, v95, v91, s64
    v_perm_b32 v67, v103, v99, s64
    v_perm_b32 v68, v79, v75, s65
    v_perm_b32 v69, v87, v83, s65
    v_perm_b32 v70, v95, v91, s65
    v_perm_b32 v71, v103, v99, s65
    s_nop 1
    v_mfma_f32_16x16x32_bf16 v[104:107], v[40:43], v[24:27], v[104:107]
    v_mfma_f32_16x16x32_bf16 v[108:111], v[44:47], v[24:27], v[108:111]
    v_mfma_f32_16x16x32_bf16 v[112:115], v[48:51], v[24:27], v[112:115]
    v_mfma_f32_16x16x32_bf16 v[116:119], v[52:55], v[24:27], v[116:119]
    v_mfma_f32_16x16x32_bf16 v[120:123], v[56:59], v[24:27], v[120:123]
    v_mfma_f32_16x16x32_bf16 v[124:127], v[60:63], v[24:27], v[124:127]
    v_mfma_f32_16x16x32_bf16 v[128:131], v[64:67], v[24:27], v[128:131]
    v_mfma_f32_16x16x32_bf16 v[132:135], v[68:71], v[24:27], v[132:135]
    s_nop 7
    s_branch L_gloop
L_gdone:
    v_mov_b32 v8, v15
    s_nop 1
    v_permlane32_swap_b32 v8, v15
    s_nop 1
    v_add_f32 v15, v8, v15
    v_mov_b32 v8, v15
    s_nop 1
    v_permlane16_swap_b32 v8, v15
    s_nop 1
    v_add_f32 v15, v8, v15
    s_barrier
    ds_write_b32 v23, v14
    s_waitcnt lgkmcnt(0)
    s_barrier
    ds_read_b128 v[40:43], v22
    ds_read_b128 v[44:47], v22 offset:16
    s_waitcnt lgkmcnt(0)
    v_max3_f32 v9, v40, v41, v42
    v_max3_f32 v9, v9, v43, v44
    v_max3_f32 v9, v9, v45, v46
    v_max_f32 v9, v9, v47
    v_sub_f32 v10, v14, v9
    v_exp_f32 v10, v10
    s_lshl_b32 s40, s32, 13
    v_mul_f32 v15, v15, v10
    v_mul_f32 v104, v104, v10
    v_mul_f32 v105, v105, v10
    v_mul_f32 v106, v106, v10
    v_mul_f32 v107, v107, v10
    v_mul_f32 v108, v108, v10
    v_mul_f32 v109, v109, v10
    v_mul_f32 v110, v110, v10
    v_mul_f32 v111, v111, v10
    v_mul_f32 v112, v112, v10
    v_mul_f32 v113, v113, v10
    v_mul_f32 v114, v114, v10
    v_mul_f32 v115, v115, v10
    v_mul_f32 v116, v116, v10
    v_mul_f32 v117, v117, v10
    v_mul_f32 v118, v118, v10
    v_mul_f32 v119, v119, v10
    v_mul_f32 v120, v120, v10
    v_mul_f32 v121, v121, v10
    v_mul_f32 v122, v122, v10
    v_mul_f32 v123, v123, v10
    v_mul_f32 v124, v124, v10
    v_mul_f32 v125, v125, v10
    v_mul_f32 v126, v126, v10
    v_mul_f32 v127, v127, v10
    v_mul_f32 v128, v128, v10
    v_mul_f32 v129, v129, v10
    v_mul_f32 v130, v130, v10
    v_mul_f32 v131, v131, v10
    v_mul_f32 v132, v132, v10
    v_mul_f32 v133, v133, v10
    v_mul_f32 v134, v134, v10
    v_mul_f32 v135, v135, v10
    ds_write_b32 v23, v15 offset:512
    v_lshlrev_b32 v8, 4, v1
    v_add_u32 v9, s40, v8
    ds_write_b128 v9, v[104:107] offset:0
    ds_write_b128 v9, v[108:111] offset:1024
    ds_write_b128 v9, v[112:115] offset:2048
    ds_write_b128 v9, v[116:119] offset:3072
    ds_write_b128 v9, v[120:123] offset:4096
    ds_write_b128 v9, v[124:127] offset:5120
    ds_write_b128 v9, v[128:131] offset:6144
    ds_write_b128 v9, v[132:135] offset:7168
    s_lshl_b32 s40, s32, 10
    v_add_u32 v9, s40, v8
    s_waitcnt lgkmcnt(0)
    s_barrier
    ds_read_b128 v[40:43], v9 offset:0
    ds_read_b128 v[44:47], v9 offset:8192
    ds_read_b128 v[48:51], v9 offset:16384
    ds_read_b128 v[52:55], v9 offset:24576
    ds_read_b128 v[56:59], v9 offset:32768
    ds_read_b128 v[60:63], v9 offset:40960
    ds_read_b128 v[64:67], v9 offset:49152
    ds_read_b128 v[68:71], v9 offset:57344
    ds_read_b128 v[72:75], v22 offset:512
    ds_read_b128 v[76:79], v22 offset:528
    s_waitcnt lgkmcnt(0)
    v_add_f32 v40, v40, v44
    v_add_f32 v41, v41, v45
    v_add_f32 v42, v42, v46
    v_add_f32 v43, v43, v47
    v_add_f32 v72, v72, v73
    v_add_f32 v40, v40, v48
    v_add_f32 v41, v41, v49
    v_add_f32 v42, v42, v50
    v_add_f32 v43, v43, v51
    v_add_f32 v72, v72, v74
    v_add_f32 v40, v40, v52
    v_add_f32 v41, v41, v53
    v_add_f32 v42, v42, v54
    v_add_f32 v43, v43, v55
    v_add_f32 v72, v72, v75
    v_add_f32 v40, v40, v56
    v_add_f32 v41, v41, v57
    v_add_f32 v42, v42, v58
    v_add_f32 v43, v43, v59
    v_add_f32 v72, v72, v76
    v_add_f32 v40, v40, v60
    v_add_f32 v41, v41, v61
    v_add_f32 v42, v42, v62
    v_add_f32 v43, v43, v63
    v_add_f32 v72, v72, v77
    v_add_f32 v40, v40, v64
    v_add_f32 v41, v41, v65
    v_add_f32 v42, v42, v66
    v_add_f32 v43, v43, v67
    v_add_f32 v72, v72, v78
    v_add_f32 v40, v40, v68
    v_add_f32 v41, v41, v69
    v_add_f32 v42, v42, v70
    v_add_f32 v43, v43, v71
    v_add_f32 v72, v72, v79
    v_rcp_f32 v72, v72
    v_lshlrev_b32 v8, 8, v2
    v_mul_f32 v40, v40, v72
    v_mul_f32 v41, v41, v72
    v_mul_f32 v42, v42, v72
    v_mul_f32 v43, v43, v72
    v_cvt_pk_bf16_f32 v40, v40, v41
    v_cvt_pk_bf16_f32 v42, v42, v43
    v_lshl_add_u32 v8, v3, 6, v8
    s_lshl_b32 s40, s32, 1
    s_add_u32 s40, s40, s38
    s_mov_b32 exec_lo, 0x000f000f
    s_mov_b32 exec_hi, 0x000f000f
    buffer_store_short v40, v8, s[28:31], s40 offen
    buffer_store_short_d16_hi v40, v8, s[28:31], s40 offen offset:16
    buffer_store_short v42, v8, s[28:31], s40 offen offset:32
    buffer_store_short_d16_hi v42, v8, s[28:31], s40 offen offset:48
    s_endpgm
.section .rodata,"a"
.p2align 6
.amdhsa_kernel standalone__paged_block_table_kv_radixattention__decode_kernel
  .amdhsa_next_free_vgpr 160
  .amdhsa_next_free_sgpr 96
  .amdhsa_accum_offset 160
  .amdhsa_group_segment_fixed_size 0
  .amdhsa_kernarg_size 64
  .amdhsa_user_sgpr_count 2
  .amdhsa_user_sgpr_kernarg_segment_ptr 1
  .amdhsa_system_sgpr_workgroup_id_x 1
.end_amdhsa_kernel
```
